```python
import torch

def _softmax(x, axis=-1):
    return torch.softmax(x, dim=axis)

def _gelu(x):
    return torch.nn.functional.gelu(x, approximate='tanh')

def _silu(x):
    return torch.nn.functional.silu(x)

def _sigmoid(x):
    return torch.sigmoid(x)

def _layernorm(x, axis=-1, eps=1e-05):
    m = x.mean(dim=axis, keepdim=True)
    v = x.var(dim=axis, keepdim=True, unbiased=False)
    return (x - m) / torch.sqrt(v + eps)

def _scatter_add(tgt, idx, src, axis=0):
    return tgt.clone().index_add_(axis, idx, src)

def _segment_sum(src, seg, n):
    out = torch.zeros((n,) + src.shape[1:], dtype=src.dtype)
    return out.index_add_(0, seg, src)

def _pad(x, pw):
    flat = tuple((v for pair in reversed(pw) for v in pair))
    return torch.nn.functional.pad(x, flat)
kernel_name = 'gather_scatter__tensor_product_equiv_mace__graph'

def setup_inputs():

    _w = lambda a: (lambda t: t.to(torch.bfloat16) if t.is_floating_point() else t)(torch.as_tensor(a))
    N, deg = (50000, 16)
    Lmax, C, De = (1, 64, 4)
    M = (Lmax + 1) ** 2
    E = N * deg
    src = (lambda lo, hi, *s: torch.randint(lo, hi, s))(0, N, E).to(torch.int64)
    dst = (lambda lo, hi, *s: torch.randint(lo, hi, s))(0, N, E).to(torch.int64)
    r = (lambda *s: torch.randn(*s, dtype=torch.bfloat16) * 0.05)(E, 3).to(float)
    r = r / (torch.linalg.norm(r, dim=-1, keepdim=True).to(float) + 1e-06)
    rx, ry, rz = (r[:, 0].clone(), r[:, 1].clone(), r[:, 2].clone())
    x2, y2, z2 = (rx * rx, ry * ry, rz * rz)
    sh_list = [torch.ones_like(rx), rx, ry, rz, rx * ry, ry * rz, 2.0 * z2 - x2 - y2, rx * rz, x2 - y2, ry * (3.0 * x2 - y2), rx * ry * rz, ry * (4.0 * z2 - x2 - y2), rz * (2.0 * z2 - 3.0 * x2 - 3.0 * y2), rx * (4.0 * z2 - x2 - y2), rz * (x2 - y2), rx * (x2 - 3.0 * y2)]
    sh16 = torch.stack(sh_list, dim=-1).to(float)
    pad = max(0, M - 16)
    sh_full = torch.cat([sh16, torch.zeros((E, pad), dtype=float)], dim=-1)[:, :M]
    cg = ((lambda *s: torch.randn(*s, dtype=torch.bfloat16) * 0.05)(M, M, M) * (1.0 / float(M))).to(float)
    return {'x': _w(((lambda *s: torch.randn(*s, dtype=torch.bfloat16) * 0.05)(N, M, C) * 0.3).to(float)), 'src': _w(src), 'dst': _w(dst), 'sh': _w(sh_full.to(float)), 'edge_attr': _w(((lambda *s: torch.randn(*s, dtype=torch.bfloat16) * 0.05)(E, De) * 0.3).to(float)), 'cg': _w(cg), 'w_r': _w(((lambda *s: torch.randn(*s, dtype=torch.bfloat16) * 0.05)(De, C) * (1.0 / float(De) ** 0.5)).to(float)), 'w_out': _w(((lambda *s: torch.randn(*s, dtype=torch.bfloat16) * 0.05)(C, C) * (1.0 / float(C) ** 0.5)).to(float))}

def reference(x, src, dst, sh, edge_attr, cg, w_r, w_out):
    N = x.shape[0]
    M = x.shape[1]
    C = x.shape[2]
    h = x[src]
    tp = torch.einsum('uvw,euc,ev->ewc', cg, h, sh)
    rw = edge_attr @ w_r
    msg = tp * rw[:, None, :]
    msg2 = msg.reshape(-1, M * C)
    agg = _segment_sum(msg2, dst, N).reshape(N, M, C)
    out = torch.einsum('nmc,cd->nmd', agg, w_out)
    return out
```

```asm
; @launch kernel=sort_kernel grid=(256,1,1) block=(1024,1,1) lds=2048
; @launch kernel=main_kernel grid=(256,1,1) block=(512,1,1) lds=114688
.amdgcn_target "amdgcn-amd-amdhsa--gfx950"
.text
.globl sort_kernel
.p2align 8
.type sort_kernel,@function
sort_kernel:
    s_cmp_ge_u32 s2, 256
    s_cbranch_scc1 A_end
    s_load_dwordx2 s[4:5], s[0:1], 8
    s_load_dwordx2 s[6:7], s[0:1], 16
    s_load_dwordx2 s[8:9], s[0:1], 24
    s_load_dwordx2 s[10:11], s[0:1], 32
    s_load_dwordx2 s[12:13], s[0:1], 80
    s_waitcnt lgkmcnt(0)
    s_mov_b32 s16, s4
    s_mov_b32 s17, s5
    s_mov_b32 s18, 3200000
    s_mov_b32 s19, 0x00020000
    s_mov_b32 s20, s6
    s_mov_b32 s21, s7
    s_mov_b32 s22, 3200000
    s_mov_b32 s23, 0x00020000
    s_mov_b32 s24, s8
    s_mov_b32 s25, s9
    s_mov_b32 s26, 6400000
    s_mov_b32 s27, 0x00020000
    s_mov_b32 s28, s10
    s_mov_b32 s29, s11
    s_mov_b32 s30, 6400000
    s_mov_b32 s31, 0x00020000
    s_mov_b32 s32, s12
    s_mov_b32 s33, s13
    s_mov_b32 s34, 263168
    s_mov_b32 s35, 0x00020000
    s_add_u32 s36, s12, 1048576
    s_addc_u32 s37, s13, 0
    s_mov_b32 s38, 3200000
    s_mov_b32 s39, 0x00020000
    s_add_u32 s40, s12, 5242880
    s_addc_u32 s41, s13, 0
    s_mov_b32 s42, 12800000
    s_mov_b32 s43, 0x00020000
    s_mul_i32 s3, s2, 3125
    v_add_u32 v1, s3, v0
    v_lshlrev_b32 v2, 2, v1
    v_lshlrev_b32 v3, 3, v1
    v_lshlrev_b32 v4, 2, v0
    v_mov_b32 v5, 0
    v_mov_b32 v6, 1
    s_mov_b32 s50, 21913099
    v_cmp_gt_u32 vcc, 256, v0
    s_and_saveexec_b64 s[46:47], vcc
    s_cbranch_execz A_z
    ds_write_b32 v4, v5
A_z:
    s_mov_b64 exec, s[46:47]
    v_cmp_gt_u32 s[48:49], 53, v0
    s_mov_b32 s44, 0
    s_mov_b32 s45, 0
    buffer_load_dword v8, v2, s[20:23], s44 offen
    buffer_load_dword v12, v2, s[16:19], s44 offen
    buffer_load_dwordx2 v[16:17], v3, s[24:27], s45 offen
    buffer_load_dwordx2 v[18:19], v3, s[28:31], s45 offen
    s_mov_b32 s44, 4096
    s_mov_b32 s45, 8192
    buffer_load_dword v9, v2, s[20:23], s44 offen
    buffer_load_dword v13, v2, s[16:19], s44 offen
    buffer_load_dwordx2 v[20:21], v3, s[24:27], s45 offen
    buffer_load_dwordx2 v[22:23], v3, s[28:31], s45 offen
    s_mov_b32 s44, 8192
    s_mov_b32 s45, 16384
    buffer_load_dword v10, v2, s[20:23], s44 offen
    buffer_load_dword v14, v2, s[16:19], s44 offen
    buffer_load_dwordx2 v[24:25], v3, s[24:27], s45 offen
    buffer_load_dwordx2 v[26:27], v3, s[28:31], s45 offen
    s_mov_b64 exec, s[48:49]
    s_cbranch_execz A_l3
    s_mov_b32 s44, 12288
    s_mov_b32 s45, 24576
    buffer_load_dword v11, v2, s[20:23], s44 offen
    buffer_load_dword v15, v2, s[16:19], s44 offen
    buffer_load_dwordx2 v[28:29], v3, s[24:27], s45 offen
    buffer_load_dwordx2 v[30:31], v3, s[28:31], s45 offen
A_l3:
    s_mov_b64 exec, -1
    s_waitcnt lgkmcnt(0)
    s_barrier
    s_waitcnt vmcnt(0)
    v_mul_hi_u32 v32, v8, s50
    v_min_u32 v32, 255, v32
    v_mul_u32_u24 v7, 196, v32
    v_sub_u32 v36, v8, v7
    v_min_u32 v36, 195, v36
    v_lshlrev_b32 v7, 2, v32
    ds_add_rtn_u32 v40, v7, v6
    s_waitcnt vmcnt(0)
    v_mul_hi_u32 v33, v9, s50
    v_min_u32 v33, 255, v33
    v_mul_u32_u24 v7, 196, v33
    v_sub_u32 v37, v9, v7
    v_min_u32 v37, 195, v37
    v_lshlrev_b32 v7, 2, v33
    ds_add_rtn_u32 v41, v7, v6
    s_waitcnt vmcnt(0)
    v_mul_hi_u32 v34, v10, s50
    v_min_u32 v34, 255, v34
    v_mul_u32_u24 v7, 196, v34
    v_sub_u32 v38, v10, v7
    v_min_u32 v38, 195, v38
    v_lshlrev_b32 v7, 2, v34
    ds_add_rtn_u32 v42, v7, v6
    s_mov_b64 exec, s[48:49]
    s_cbranch_execz A_h3
    s_waitcnt vmcnt(0)
    v_mul_hi_u32 v35, v11, s50
    v_min_u32 v35, 255, v35
    v_mul_u32_u24 v7, 196, v35
    v_sub_u32 v39, v11, v7
    v_min_u32 v39, 195, v39
    v_lshlrev_b32 v7, 2, v35
    ds_add_rtn_u32 v43, v7, v6
A_h3:
    s_mov_b64 exec, -1
    s_waitcnt lgkmcnt(0)
    s_barrier
    v_lshrrev_b32 v7, 6, v0
    s_nop 0
    v_readfirstlane_b32 s51, v7
    s_cmp_ge_u32 s51, 4
    s_cbranch_scc1 A_s1
    ds_read_b32 v44, v4
    s_waitcnt lgkmcnt(0)
    v_mov_b32 v45, v44
    v_and_b32 v60, 63, v0
    v_subrev_u32 v61, 1, v60
    v_lshlrev_b32 v61, 2, v61
    ds_bpermute_b32 v61, v61, v45
    v_cmp_le_u32 vcc, 1, v60
    s_waitcnt lgkmcnt(0)
    v_cndmask_b32 v61, 0, v61, vcc
    v_add_u32 v45, v45, v61
    v_subrev_u32 v61, 2, v60
    v_lshlrev_b32 v61, 2, v61
    ds_bpermute_b32 v61, v61, v45
    v_cmp_le_u32 vcc, 2, v60
    s_waitcnt lgkmcnt(0)
    v_cndmask_b32 v61, 0, v61, vcc
    v_add_u32 v45, v45, v61
    v_subrev_u32 v61, 4, v60
    v_lshlrev_b32 v61, 2, v61
    ds_bpermute_b32 v61, v61, v45
    v_cmp_le_u32 vcc, 4, v60
    s_waitcnt lgkmcnt(0)
    v_cndmask_b32 v61, 0, v61, vcc
    v_add_u32 v45, v45, v61
    v_subrev_u32 v61, 8, v60
    v_lshlrev_b32 v61, 2, v61
    ds_bpermute_b32 v61, v61, v45
    v_cmp_le_u32 vcc, 8, v60
    s_waitcnt lgkmcnt(0)
    v_cndmask_b32 v61, 0, v61, vcc
    v_add_u32 v45, v45, v61
    v_subrev_u32 v61, 16, v60
    v_lshlrev_b32 v61, 2, v61
    ds_bpermute_b32 v61, v61, v45
    v_cmp_le_u32 vcc, 16, v60
    s_waitcnt lgkmcnt(0)
    v_cndmask_b32 v61, 0, v61, vcc
    v_add_u32 v45, v45, v61
    v_subrev_u32 v61, 32, v60
    v_lshlrev_b32 v61, 2, v61
    ds_bpermute_b32 v61, v61, v45
    v_cmp_le_u32 vcc, 32, v60
    s_waitcnt lgkmcnt(0)
    v_cndmask_b32 v61, 0, v61, vcc
    v_add_u32 v45, v45, v61
    s_nop 1
    v_readlane_b32 s52, v45, 63
    v_mov_b32 v7, s51
    v_lshlrev_b32 v7, 2, v7
    v_mov_b32 v46, s52
    ds_write_b32 v7, v46 offset:1024
A_s1:
    s_waitcnt lgkmcnt(0)
    s_barrier
    s_cmp_ge_u32 s51, 4
    s_cbranch_scc1 A_s2
    ds_read_b128 v[48:51], v5 offset:1024
    s_waitcnt lgkmcnt(0)
    v_sub_u32 v45, v45, v44
    s_cmp_gt_u32 s51, 0
    s_cselect_b32 s52, -1, 0
    v_and_b32 v7, s52, v48
    v_add_u32 v45, v45, v7
    s_cmp_gt_u32 s51, 1
    s_cselect_b32 s52, -1, 0
    v_and_b32 v7, s52, v49
    v_add_u32 v45, v45, v7
    s_cmp_gt_u32 s51, 2
    s_cselect_b32 s52, -1, 0
    v_and_b32 v7, s52, v50
    v_add_u32 v45, v45, v7
    ds_write_b32 v4, v45
    s_lshl_b32 s53, s2, 2
    v_lshlrev_b32 v7, 10, v0
    v_add_u32 v7, s53, v7
    buffer_store_dword v45, v7, s[32:35], 0 offen
    v_add_u32 v7, 1024, v7
    v_add_u32 v46, v45, v44
    v_cmp_eq_u32 vcc, 255, v0
    s_and_saveexec_b64 s[46:47], vcc
    s_cbranch_execz A_s3
    buffer_store_dword v46, v7, s[32:35], 0 offen
A_s3:
    s_mov_b64 exec, -1
A_s2:
    s_waitcnt lgkmcnt(0)
    s_barrier
    v_lshlrev_b32 v7, 2, v32
    ds_read_b32 v44, v7
    v_and_b32 v12, 0xffff, v12
    v_lshl_or_b32 v12, v36, 16, v12
    s_waitcnt lgkmcnt(0)
    v_add3_u32 v44, v44, v40, s3
    v_lshlrev_b32 v45, 2, v44
    v_lshlrev_b32 v46, 4, v44
    buffer_store_dword v12, v45, s[36:39], 0 offen
    buffer_store_dwordx4 v[16:19], v46, s[40:43], 0 offen
    v_lshlrev_b32 v7, 2, v33
    ds_read_b32 v44, v7
    v_and_b32 v13, 0xffff, v13
    v_lshl_or_b32 v13, v37, 16, v13
    s_waitcnt lgkmcnt(0)
    v_add3_u32 v44, v44, v41, s3
    v_lshlrev_b32 v45, 2, v44
    v_lshlrev_b32 v46, 4, v44
    buffer_store_dword v13, v45, s[36:39], 0 offen
    buffer_store_dwordx4 v[20:23], v46, s[40:43], 0 offen
    v_lshlrev_b32 v7, 2, v34
    ds_read_b32 v44, v7
    v_and_b32 v14, 0xffff, v14
    v_lshl_or_b32 v14, v38, 16, v14
    s_waitcnt lgkmcnt(0)
    v_add3_u32 v44, v44, v42, s3
    v_lshlrev_b32 v45, 2, v44
    v_lshlrev_b32 v46, 4, v44
    buffer_store_dword v14, v45, s[36:39], 0 offen
    buffer_store_dwordx4 v[24:27], v46, s[40:43], 0 offen
    s_mov_b64 exec, s[48:49]
    s_cbranch_execz A_w3
    v_lshlrev_b32 v7, 2, v35
    ds_read_b32 v44, v7
    v_and_b32 v15, 0xffff, v15
    v_lshl_or_b32 v15, v39, 16, v15
    s_waitcnt lgkmcnt(0)
    v_add3_u32 v44, v44, v43, s3
    v_lshlrev_b32 v45, 2, v44
    v_lshlrev_b32 v46, 4, v44
    buffer_store_dword v15, v45, s[36:39], 0 offen
    buffer_store_dwordx4 v[28:31], v46, s[40:43], 0 offen
A_w3:
A_end:
    s_endpgm
.globl main_kernel
.p2align 8
.type main_kernel,@function
main_kernel:
    s_cmp_ge_u32 s2, 256
    s_cbranch_scc1 B_end
    s_load_dwordx2 s[4:5], s[0:1], 0
    s_load_dwordx2 s[6:7], s[0:1], 40
    s_load_dwordx2 s[8:9], s[0:1], 48
    s_load_dwordx2 s[10:11], s[0:1], 56
    s_load_dwordx2 s[12:13], s[0:1], 64
    s_load_dwordx2 s[14:15], s[0:1], 80
    s_waitcnt lgkmcnt(0)
    s_mov_b32 s16, s4
    s_mov_b32 s17, s5
    s_mov_b32 s18, 25600000
    s_mov_b32 s19, 0x00020000
    s_mov_b32 s20, s12
    s_mov_b32 s21, s13
    s_mov_b32 s22, 25600000
    s_mov_b32 s23, 0x00020000
    s_mov_b32 s24, s6
    s_mov_b32 s25, s7
    s_mov_b32 s26, 128
    s_mov_b32 s27, 0x00020000
    s_mov_b32 s28, s8
    s_mov_b32 s29, s9
    s_mov_b32 s30, 512
    s_mov_b32 s31, 0x00020000
    s_mov_b32 s32, s10
    s_mov_b32 s33, s11
    s_mov_b32 s34, 8192
    s_mov_b32 s35, 0x00020000
    s_mov_b32 s36, s14
    s_mov_b32 s37, s15
    s_mov_b32 s38, 263168
    s_mov_b32 s39, 0x00020000
    s_add_u32 s40, s14, 1048576
    s_addc_u32 s41, s15, 0
    s_mov_b32 s42, 3200000
    s_mov_b32 s43, 0x00020000
    s_add_u32 s44, s14, 5242880
    s_addc_u32 s45, s15, 0
    s_mov_b32 s46, 12800000
    s_mov_b32 s47, 0x00020000
    s_add_u32 s84, s14, 33554432
    s_addc_u32 s85, s15, 0
    s_mov_b32 s86, 51380224
    s_mov_b32 s87, 0x00020000
    s_mul_i32 s3, s2, 196
    s_sub_u32 s60, 50000, s3
    s_min_u32 s60, s60, 196
    v_and_b32 v4, 63, v0
    v_and_b32 v5, 15, v4
    v_lshrrev_b32 v6, 4, v4
    v_lshrrev_b32 v7, 6, v0
    s_nop 0
    v_readfirstlane_b32 s61, v7
    v_lshlrev_b32 v1, 3, v5
    v_lshlrev_b32 v2, 1, v6
    v_lshrrev_b32 v8, 2, v5
    v_and_b32 v9, 3, v5
    v_and_b32 v10, 1, v9
    v_xor_b32 v10, 1, v10
    v_lshlrev_b32 v3, 4, v10
    v_cmp_lt_u32 s[62:63], 1, v9
    v_lshlrev_b32 v10, 1, v8
    buffer_load_ushort v16, v10, s[24:27], 0 offen offset:0
    buffer_load_ushort v17, v10, s[24:27], 0 offen offset:8
    buffer_load_ushort v18, v10, s[24:27], 0 offen offset:16
    buffer_load_ushort v19, v10, s[24:27], 0 offen offset:24
    buffer_load_ushort v20, v10, s[24:27], 0 offen offset:32
    buffer_load_ushort v21, v10, s[24:27], 0 offen offset:40
    buffer_load_ushort v22, v10, s[24:27], 0 offen offset:48
    buffer_load_ushort v23, v10, s[24:27], 0 offen offset:56
    buffer_load_ushort v24, v10, s[24:27], 0 offen offset:64
    buffer_load_ushort v25, v10, s[24:27], 0 offen offset:72
    buffer_load_ushort v26, v10, s[24:27], 0 offen offset:80
    buffer_load_ushort v27, v10, s[24:27], 0 offen offset:88
    buffer_load_ushort v28, v10, s[24:27], 0 offen offset:96
    buffer_load_ushort v29, v10, s[24:27], 0 offen offset:104
    buffer_load_ushort v30, v10, s[24:27], 0 offen offset:112
    buffer_load_ushort v31, v10, s[24:27], 0 offen offset:120
    buffer_load_dwordx2 v[84:85], v1, s[28:31], 0 offen offset:0
    buffer_load_dwordx2 v[86:87], v1, s[28:31], 0 offen offset:128
    buffer_load_dwordx2 v[88:89], v1, s[28:31], 0 offen offset:256
    buffer_load_dwordx2 v[90:91], v1, s[28:31], 0 offen offset:384
    s_lshr_b32 s50, s61, 1
    s_and_b32 s51, s61, 1
    s_lshl_b32 s50, s50, 3
    s_lshl_b32 s51, s51, 12
    s_add_u32 s50, s50, s51
    v_lshlrev_b32 v10, 5, v8
    v_lshl_add_u32 v10, v9, 1, v10
    v_lshl_add_u32 v10, v6, 10, v10
    buffer_load_ushort v92, v10, s[32:35], s50 offen offset:0
    buffer_load_ushort v96, v10, s[32:35], s50 offen offset:128
    buffer_load_ushort v93, v10, s[32:35], s50 offen offset:256
    buffer_load_ushort v97, v10, s[32:35], s50 offen offset:384
    buffer_load_ushort v94, v10, s[32:35], s50 offen offset:512
    buffer_load_ushort v98, v10, s[32:35], s50 offen offset:640
    buffer_load_ushort v95, v10, s[32:35], s50 offen offset:768
    buffer_load_ushort v99, v10, s[32:35], s50 offen offset:896
    v_lshrrev_b32 v11, 1, v0
    v_and_b32 v12, 1, v0
    s_lshl_b32 s52, s2, 10
    v_lshl_add_u32 v13, v11, 2, s52
    buffer_load_dword v14, v13, s[36:39], 0 offen
    buffer_load_dword v15, v13, s[36:39], 0 offen offset:1024
    v_mov_b32 v10, 0
    v_lshlrev_b32 v13, 2, v0
    v_cmp_gt_u32 vcc, 264, v0
    s_and_saveexec_b64 s[54:55], vcc
    s_cbranch_execz B_z
    ds_write_b32 v13, v10 offset:0
B_z:
    s_mov_b64 exec, -1
    ds_write_b32 v10, v10 offset:4096
    s_waitcnt vmcnt(0)
    v_lshlrev_b32 v16, 16, v16
    v_lshlrev_b32 v17, 16, v17
    v_lshlrev_b32 v18, 16, v18
    v_lshlrev_b32 v19, 16, v19
    v_lshlrev_b32 v20, 16, v20
    v_lshlrev_b32 v21, 16, v21
    v_lshlrev_b32 v22, 16, v22
    v_lshlrev_b32 v23, 16, v23
    v_lshlrev_b32 v24, 16, v24
    v_lshlrev_b32 v25, 16, v25
    v_lshlrev_b32 v26, 16, v26
    v_lshlrev_b32 v27, 16, v27
    v_lshlrev_b32 v28, 16, v28
    v_lshlrev_b32 v29, 16, v29
    v_lshlrev_b32 v30, 16, v30
    v_lshlrev_b32 v31, 16, v31
    v_lshlrev_b32 v32, 16, v84
    v_and_b32 v33, 0xffff0000, v84
    v_lshlrev_b32 v34, 16, v85
    v_and_b32 v35, 0xffff0000, v85
    v_lshlrev_b32 v36, 16, v86
    v_and_b32 v37, 0xffff0000, v86
    v_lshlrev_b32 v38, 16, v87
    v_and_b32 v39, 0xffff0000, v87
    v_lshlrev_b32 v40, 16, v88
    v_and_b32 v41, 0xffff0000, v88
    v_lshlrev_b32 v42, 16, v89
    v_and_b32 v43, 0xffff0000, v89
    v_lshlrev_b32 v44, 16, v90
    v_and_b32 v45, 0xffff0000, v90
    v_lshlrev_b32 v46, 16, v91
    v_and_b32 v47, 0xffff0000, v91
    v_lshl_or_b32 v92, v96, 16, v92
    v_lshl_or_b32 v93, v97, 16, v93
    v_lshl_or_b32 v94, v98, 16, v94
    v_lshl_or_b32 v95, v99, 16, v95
    v_lshlrev_b32 v10, 4, v0
    ds_write_b128 v10, v[92:95] offset:8192
    v_mul_u32_u24 v10, 3125, v11
    v_add_u32 v15, v15, v10
    v_add3_u32 v14, v14, v10, v12
    s_waitcnt lgkmcnt(0)
    s_barrier
    v_mov_b32 v102, 1
    s_cmp_ge_u32 s61, 4
    s_cbranch_scc1 R_s1
    v_lshl_add_u32 v13, v0, 2, s52
    buffer_load_dword v10, v13, s[36:39], 0 offen
    buffer_load_dword v11, v13, s[36:39], 0 offen offset:1024
    s_waitcnt vmcnt(0)
    v_sub_u32 v10, v11, v10
    v_mov_b32 v11, v10
    v_and_b32 v60, 63, v0
    v_subrev_u32 v61, 1, v60
    v_lshlrev_b32 v61, 2, v61
    ds_bpermute_b32 v61, v61, v11
    v_cmp_le_u32 vcc, 1, v60
    s_waitcnt lgkmcnt(0)
    v_cndmask_b32 v61, 0, v61, vcc
    v_add_u32 v11, v11, v61
    v_subrev_u32 v61, 2, v60
    v_lshlrev_b32 v61, 2, v61
    ds_bpermute_b32 v61, v61, v11
    v_cmp_le_u32 vcc, 2, v60
    s_waitcnt lgkmcnt(0)
    v_cndmask_b32 v61, 0, v61, vcc
    v_add_u32 v11, v11, v61
    v_subrev_u32 v61, 4, v60
    v_lshlrev_b32 v61, 2, v61
    ds_bpermute_b32 v61, v61, v11
    v_cmp_le_u32 vcc, 4, v60
    s_waitcnt lgkmcnt(0)
    v_cndmask_b32 v61, 0, v61, vcc
    v_add_u32 v11, v11, v61
    v_subrev_u32 v61, 8, v60
    v_lshlrev_b32 v61, 2, v61
    ds_bpermute_b32 v61, v61, v11
    v_cmp_le_u32 vcc, 8, v60
    s_waitcnt lgkmcnt(0)
    v_cndmask_b32 v61, 0, v61, vcc
    v_add_u32 v11, v11, v61
    v_subrev_u32 v61, 16, v60
    v_lshlrev_b32 v61, 2, v61
    ds_bpermute_b32 v61, v61, v11
    v_cmp_le_u32 vcc, 16, v60
    s_waitcnt lgkmcnt(0)
    v_cndmask_b32 v61, 0, v61, vcc
    v_add_u32 v11, v11, v61
    v_subrev_u32 v61, 32, v60
    v_lshlrev_b32 v61, 2, v61
    ds_bpermute_b32 v61, v61, v11
    v_cmp_le_u32 vcc, 32, v60
    s_waitcnt lgkmcnt(0)
    v_cndmask_b32 v61, 0, v61, vcc
    v_add_u32 v11, v11, v61
    s_nop 1
    v_readlane_b32 s53, v11, 63
    s_lshl_b32 s54, s61, 2
    v_mov_b32 v12, s54
    v_mov_b32 v9, s53
    ds_write_b32 v12, v9 offset:4112
R_s1:
    s_waitcnt lgkmcnt(0)
    s_barrier
    v_mov_b32 v12, 0
    ds_read_b128 v[84:87], v12 offset:4112
    s_waitcnt lgkmcnt(0)
    v_add3_u32 v12, v84, v85, v86
    v_add_u32 v12, v12, v87
    s_nop 0
    v_readfirstlane_b32 s88, v12
    s_cmp_ge_u32 s61, 4
    s_cbranch_scc1 R_s2
    v_sub_u32 v11, v11, v10
    s_cmp_gt_u32 s61, 0
    s_cselect_b32 s53, -1, 0
    v_and_b32 v12, s53, v84
    v_add_u32 v11, v11, v12
    s_cmp_gt_u32 s61, 1
    s_cselect_b32 s53, -1, 0
    v_and_b32 v12, s53, v85
    v_add_u32 v11, v11, v12
    s_cmp_gt_u32 s61, 2
    s_cselect_b32 s53, -1, 0
    v_and_b32 v12, s53, v86
    v_add_u32 v11, v11, v12
    v_lshlrev_b32 v13, 2, v0
    ds_write_b32 v13, v11 offset:5120
R_s2:
    s_waitcnt lgkmcnt(0)
    s_barrier
    v_lshrrev_b32 v13, 1, v0
    v_lshlrev_b32 v13, 2, v13
    ds_read_b32 v103, v13 offset:5120
    s_mov_b32 s53, 4423242
    s_waitcnt lgkmcnt(0)
    v_mul_hi_u32 v103, v103, s53
    s_mul_hi_u32 s89, s88, s53
    s_add_u32 s89, s89, 1
    s_cmp_le_u32 s88, 4096
    s_cselect_b32 s89, 1, s89
    s_cselect_b32 s53, 0, -1
    v_and_b32 v103, s53, v103
    s_mov_b32 s90, 0
    s_mul_i32 s91, s2, 200704
R_loop:
    v_mov_b32 v10, 0
    v_lshlrev_b32 v13, 2, v0
    v_cmp_gt_u32 vcc, 264, v0
    s_and_saveexec_b64 s[54:55], vcc
    s_cbranch_execz R_z
    ds_write_b32 v13, v10 offset:0
R_z:
    s_mov_b64 exec, -1
    ds_write_b32 v10, v10 offset:4096
    s_waitcnt lgkmcnt(0)
    s_barrier
    v_cmp_eq_u32 vcc, s90, v103
    s_nop 1
    v_cndmask_b32 v10, v15, v14, vcc
pl_1:
    v_cmp_lt_u32 vcc, v10, v15
    s_and_b64 exec, exec, vcc
    s_cbranch_execz pe_2
    v_lshlrev_b32 v13, 2, v10
    buffer_load_dword v11, v13, s[40:43], 0 offen
    s_waitcnt vmcnt(0)
    v_lshrrev_b32 v12, 14, v11
    v_and_b32 v12, 0x3fc, v12
    ds_add_u32 v12, v102 offset:0
    v_add_u32 v10, 2, v10
    s_branch pl_1
pe_2:
    s_mov_b64 exec, -1
    s_waitcnt lgkmcnt(0)
    s_barrier
    s_cmp_ge_u32 s61, 4
    s_cbranch_scc1 B_s1
    v_lshlrev_b32 v13, 2, v0
    ds_read_b32 v10, v13 offset:0
    s_waitcnt lgkmcnt(0)
    v_mov_b32 v11, v10
    v_and_b32 v60, 63, v0
    v_subrev_u32 v61, 1, v60
    v_lshlrev_b32 v61, 2, v61
    ds_bpermute_b32 v61, v61, v11
    v_cmp_le_u32 vcc, 1, v60
    s_waitcnt lgkmcnt(0)
    v_cndmask_b32 v61, 0, v61, vcc
    v_add_u32 v11, v11, v61
    v_subrev_u32 v61, 2, v60
    v_lshlrev_b32 v61, 2, v61
    ds_bpermute_b32 v61, v61, v11
    v_cmp_le_u32 vcc, 2, v60
    s_waitcnt lgkmcnt(0)
    v_cndmask_b32 v61, 0, v61, vcc
    v_add_u32 v11, v11, v61
    v_subrev_u32 v61, 4, v60
    v_lshlrev_b32 v61, 2, v61
    ds_bpermute_b32 v61, v61, v11
    v_cmp_le_u32 vcc, 4, v60
    s_waitcnt lgkmcnt(0)
    v_cndmask_b32 v61, 0, v61, vcc
    v_add_u32 v11, v11, v61
    v_subrev_u32 v61, 8, v60
    v_lshlrev_b32 v61, 2, v61
    ds_bpermute_b32 v61, v61, v11
    v_cmp_le_u32 vcc, 8, v60
    s_waitcnt lgkmcnt(0)
    v_cndmask_b32 v61, 0, v61, vcc
    v_add_u32 v11, v11, v61
    v_subrev_u32 v61, 16, v60
    v_lshlrev_b32 v61, 2, v61
    ds_bpermute_b32 v61, v61, v11
    v_cmp_le_u32 vcc, 16, v60
    s_waitcnt lgkmcnt(0)
    v_cndmask_b32 v61, 0, v61, vcc
    v_add_u32 v11, v11, v61
    v_subrev_u32 v61, 32, v60
    v_lshlrev_b32 v61, 2, v61
    ds_bpermute_b32 v61, v61, v11
    v_cmp_le_u32 vcc, 32, v60
    s_waitcnt lgkmcnt(0)
    v_cndmask_b32 v61, 0, v61, vcc
    v_add_u32 v11, v11, v61
    s_nop 1
    v_readlane_b32 s52, v11, 63
    s_lshl_b32 s53, s61, 2
    v_mov_b32 v12, s53
    v_mov_b32 v9, s52
    ds_write_b32 v12, v9 offset:4112
B_s1:
    s_waitcnt lgkmcnt(0)
    s_barrier
    s_cmp_ge_u32 s61, 4
    s_cbranch_scc1 B_s2
    v_mov_b32 v12, 0
    ds_read_b128 v[84:87], v12 offset:4112
    s_waitcnt lgkmcnt(0)
    v_sub_u32 v11, v11, v10
    s_cmp_gt_u32 s61, 0
    s_cselect_b32 s52, -1, 0
    v_and_b32 v12, s52, v84
    v_add_u32 v11, v11, v12
    s_cmp_gt_u32 s61, 1
    s_cselect_b32 s52, -1, 0
    v_and_b32 v12, s52, v85
    v_add_u32 v11, v11, v12
    s_cmp_gt_u32 s61, 2
    s_cselect_b32 s52, -1, 0
    v_and_b32 v12, s52, v86
    v_add_u32 v11, v11, v12
    ds_write_b32 v13, v11 offset:0
    ds_write_b32 v13, v11 offset:2048
B_s2:
    s_waitcnt lgkmcnt(0)
    s_barrier
    v_cmp_eq_u32 vcc, s90, v103
    s_nop 1
    v_cndmask_b32 v10, v15, v14, vcc
pl_3:
    v_cmp_lt_u32 vcc, v10, v15
    s_and_b64 exec, exec, vcc
    s_cbranch_execz pe_4
    v_lshlrev_b32 v13, 2, v10
    buffer_load_dword v11, v13, s[40:43], 0 offen
    v_lshlrev_b32 v13, 4, v10
    buffer_load_dwordx4 v[84:87], v13, s[44:47], 0 offen
    s_waitcnt vmcnt(0)
    v_lshrrev_b32 v12, 14, v11
    v_and_b32 v12, 0x3fc, v12
    ds_add_rtn_u32 v12, v12, v102 offset:2048
    v_and_b32 v11, 0xffff, v11
    s_waitcnt lgkmcnt(0)
    v_min_u32 v12, 4095, v12
    v_lshlrev_b32 v13, 2, v12
    ds_write_b32 v13, v11 offset:32768
    v_lshlrev_b32 v13, 4, v12
    ds_write_b128 v13, v[84:87] offset:49152
    v_add_u32 v10, 2, v10
    s_branch pl_3
pe_4:
    s_mov_b64 exec, -1
    s_waitcnt lgkmcnt(0)
    s_barrier
    s_mov_b32 s56, 0
    s_mov_b32 s57, 0
    s_mov_b32 s58, 0
    s_mov_b32 s59, 0
    s_mov_b32 s48, 0x05040100
    s_mov_b32 s49, 0x07060302
    s_lshl_b32 s79, s61, 11
    s_add_u32 s79, s79, 16384
    v_mov_b32 v48, 0
    v_mov_b32 v49, 0
    v_mov_b32 v50, 0
    v_mov_b32 v51, 0
    v_mov_b32 v52, 0
    v_mov_b32 v53, 0
    v_mov_b32 v54, 0
    v_mov_b32 v55, 0
    v_mov_b32 v56, 0
    v_mov_b32 v57, 0
    v_mov_b32 v58, 0
    v_mov_b32 v59, 0
    v_mov_b32 v60, 0
    v_mov_b32 v61, 0
    v_mov_b32 v62, 0
    v_mov_b32 v63, 0
    v_mov_b32 v101, 0x80000000
    v_mov_b32 v100, -1
    s_cmp_lt_u32 s56, s57
    s_cbranch_scc1 nh_5
    s_mov_b64 exec, 1
    v_mov_b32 v10, 0
    ds_add_rtn_u32 v10, v10, v102 offset:4096
    s_waitcnt lgkmcnt(0)
    v_readfirstlane_b32 s58, v10
    s_mov_b64 exec, -1
    s_cmp_ge_u32 s58, s60
    s_cbranch_scc1 nd_6
    s_lshl_b32 s52, s58, 2
    v_mov_b32 v10, s52
    v_add_u32 v12, 0, v10
    ds_read2_b32 v[10:11], v12 offset0:0 offset1:1
    s_waitcnt lgkmcnt(0)
    v_readfirstlane_b32 s56, v10
    v_readfirstlane_b32 s57, v11
    s_branch nh_5
nd_6:
    s_mov_b32 s58, -1
    s_mov_b32 s56, 0
    s_mov_b32 s57, 0
nh_5:
    s_mov_b32 s64, s56
    s_mov_b32 s65, s57
    s_mov_b32 s66, s58
    s_add_u32 s56, s56, 8
    v_add_u32 v10, s64, v2
    v_lshlrev_b32 v11, 2, v10
    v_add_u32 v11, 32768, v11
    ds_read2_b32 v[12:13], v11 offset0:0 offset1:1
    v_add_u32 v11, 1, v10
    v_cmp_gt_u32 vcc, s65, v10
    v_cmp_gt_u32 s[54:55], s65, v11
    s_waitcnt lgkmcnt(0)
    v_lshl_add_u32 v12, v12, 9, v1
    v_lshl_add_u32 v13, v13, 9, v1
    v_cndmask_b32 v12, v101, v12, vcc
    v_cndmask_b32 v13, v101, v13, s[54:55]
    buffer_load_dwordx2 v[104:105], v12, s[16:19], 0 offen offset:0
    buffer_load_dwordx2 v[106:107], v12, s[16:19], 0 offen offset:128
    buffer_load_dwordx2 v[108:109], v12, s[16:19], 0 offen offset:256
    buffer_load_dwordx2 v[110:111], v12, s[16:19], 0 offen offset:384
    buffer_load_dwordx2 v[112:113], v13, s[16:19], 0 offen offset:0
    buffer_load_dwordx2 v[114:115], v13, s[16:19], 0 offen offset:128
    buffer_load_dwordx2 v[116:117], v13, s[16:19], 0 offen offset:256
    buffer_load_dwordx2 v[118:119], v13, s[16:19], 0 offen offset:384
    s_cmp_lt_u32 s56, s57
    s_cbranch_scc1 nh_8
    s_mov_b64 exec, 1
    v_mov_b32 v10, 0
    ds_add_rtn_u32 v10, v10, v102 offset:4096
    s_waitcnt lgkmcnt(0)
    v_readfirstlane_b32 s58, v10
    s_mov_b64 exec, -1
    s_cmp_ge_u32 s58, s60
    s_cbranch_scc1 nd_9
    s_lshl_b32 s52, s58, 2
    v_mov_b32 v10, s52
    v_add_u32 v12, 0, v10
    ds_read2_b32 v[10:11], v12 offset0:0 offset1:1
    s_waitcnt lgkmcnt(0)
    v_readfirstlane_b32 s56, v10
    v_readfirstlane_b32 s57, v11
    s_branch nh_8
nd_9:
    s_mov_b32 s58, -1
    s_mov_b32 s56, 0
    s_mov_b32 s57, 0
nh_8:
    s_mov_b32 s67, s56
    s_mov_b32 s68, s57
    s_mov_b32 s69, s58
    s_add_u32 s56, s56, 8
    v_add_u32 v10, s67, v2
    v_lshlrev_b32 v11, 2, v10
    v_add_u32 v11, 32768, v11
    ds_read2_b32 v[12:13], v11 offset0:0 offset1:1
    v_add_u32 v11, 1, v10
    v_cmp_gt_u32 vcc, s68, v10
    v_cmp_gt_u32 s[54:55], s68, v11
    s_waitcnt lgkmcnt(0)
    v_lshl_add_u32 v12, v12, 9, v1
    v_lshl_add_u32 v13, v13, 9, v1
    v_cndmask_b32 v12, v101, v12, vcc
    v_cndmask_b32 v13, v101, v13, s[54:55]
    buffer_load_dwordx2 v[120:121], v12, s[16:19], 0 offen offset:0
    buffer_load_dwordx2 v[122:123], v12, s[16:19], 0 offen offset:128
    buffer_load_dwordx2 v[124:125], v12, s[16:19], 0 offen offset:256
    buffer_load_dwordx2 v[126:127], v12, s[16:19], 0 offen offset:384
    buffer_load_dwordx2 v[128:129], v13, s[16:19], 0 offen offset:0
    buffer_load_dwordx2 v[130:131], v13, s[16:19], 0 offen offset:128
    buffer_load_dwordx2 v[132:133], v13, s[16:19], 0 offen offset:256
    buffer_load_dwordx2 v[134:135], v13, s[16:19], 0 offen offset:384
B_loop:
    s_cmp_lt_u32 s56, s57
    s_cbranch_scc1 nh_11
    s_mov_b64 exec, 1
    v_mov_b32 v10, 0
    ds_add_rtn_u32 v10, v10, v102 offset:4096
    s_waitcnt lgkmcnt(0)
    v_readfirstlane_b32 s58, v10
    s_mov_b64 exec, -1
    s_cmp_ge_u32 s58, s60
    s_cbranch_scc1 nd_12
    s_lshl_b32 s52, s58, 2
    v_mov_b32 v10, s52
    v_add_u32 v12, 0, v10
    ds_read2_b32 v[10:11], v12 offset0:0 offset1:1
    s_waitcnt lgkmcnt(0)
    v_readfirstlane_b32 s56, v10
    v_readfirstlane_b32 s57, v11
    s_branch nh_11
nd_12:
    s_mov_b32 s58, -1
    s_mov_b32 s56, 0
    s_mov_b32 s57, 0
nh_11:
    s_mov_b32 s70, s56
    s_mov_b32 s71, s57
    s_mov_b32 s72, s58
    s_add_u32 s56, s56, 8
    v_add_u32 v10, s70, v2
    v_lshlrev_b32 v11, 2, v10
    v_add_u32 v11, 32768, v11
    ds_read2_b32 v[12:13], v11 offset0:0 offset1:1
    v_add_u32 v11, 1, v10
    v_cmp_gt_u32 vcc, s71, v10
    v_cmp_gt_u32 s[54:55], s71, v11
    s_waitcnt lgkmcnt(0)
    v_lshl_add_u32 v12, v12, 9, v1
    v_lshl_add_u32 v13, v13, 9, v1
    v_cndmask_b32 v12, v101, v12, vcc
    v_cndmask_b32 v13, v101, v13, s[54:55]
    buffer_load_dwordx2 v[136:137], v12, s[16:19], 0 offen offset:0
    buffer_load_dwordx2 v[138:139], v12, s[16:19], 0 offen offset:128
    buffer_load_dwordx2 v[140:141], v12, s[16:19], 0 offen offset:256
    buffer_load_dwordx2 v[142:143], v12, s[16:19], 0 offen offset:384
    buffer_load_dwordx2 v[144:145], v13, s[16:19], 0 offen offset:0
    buffer_load_dwordx2 v[146:147], v13, s[16:19], 0 offen offset:128
    buffer_load_dwordx2 v[148:149], v13, s[16:19], 0 offen offset:256
    buffer_load_dwordx2 v[150:151], v13, s[16:19], 0 offen offset:384
    s_cmp_eq_u32 s66, -1
    s_cbranch_scc1 B_done
    v_add_u32 v10, s64, v2
    v_lshlrev_b32 v11, 4, v10
    ds_read_b128 v[76:79], v11 offset:49152
    ds_read_b128 v[80:83], v11 offset:49168
    v_add_u32 v11, 1, v10
    v_cmp_gt_u32 vcc, s65, v10
    v_cmp_gt_u32 s[54:55], s65, v11
    s_waitcnt lgkmcnt(0)
    v_lshlrev_b32 v84, 16, v76
    v_and_b32 v85, 0xffff0000, v76
    v_lshlrev_b32 v86, 16, v77
    v_and_b32 v87, 0xffff0000, v77
    v_cndmask_b32 v88, v78, v79, s[62:63]
    v_lshlrev_b32 v88, v3, v88
    v_and_b32 v88, 0xffff0000, v88
    v_cndmask_b32 v88, 0, v88, vcc
    v_mul_f32 v92, v16, v84
    v_fmac_f32 v92, v17, v85
    v_fmac_f32 v92, v18, v86
    v_fmac_f32 v92, v19, v87
    v_mul_f32 v92, v92, v88
    v_mul_f32 v93, v20, v84
    v_fmac_f32 v93, v21, v85
    v_fmac_f32 v93, v22, v86
    v_fmac_f32 v93, v23, v87
    v_mul_f32 v93, v93, v88
    v_mul_f32 v94, v24, v84
    v_fmac_f32 v94, v25, v85
    v_fmac_f32 v94, v26, v86
    v_fmac_f32 v94, v27, v87
    v_mul_f32 v94, v94, v88
    v_mul_f32 v95, v28, v84
    v_fmac_f32 v95, v29, v85
    v_fmac_f32 v95, v30, v86
    v_fmac_f32 v95, v31, v87
    v_mul_f32 v95, v95, v88
    v_lshlrev_b32 v84, 16, v80
    v_and_b32 v85, 0xffff0000, v80
    v_lshlrev_b32 v86, 16, v81
    v_and_b32 v87, 0xffff0000, v81
    v_cndmask_b32 v88, v82, v83, s[62:63]
    v_lshlrev_b32 v88, v3, v88
    v_and_b32 v88, 0xffff0000, v88
    v_cndmask_b32 v88, 0, v88, s[54:55]
    v_mul_f32 v96, v16, v84
    v_fmac_f32 v96, v17, v85
    v_fmac_f32 v96, v18, v86
    v_fmac_f32 v96, v19, v87
    v_mul_f32 v96, v96, v88
    v_mul_f32 v97, v20, v84
    v_fmac_f32 v97, v21, v85
    v_fmac_f32 v97, v22, v86
    v_fmac_f32 v97, v23, v87
    v_mul_f32 v97, v97, v88
    v_mul_f32 v98, v24, v84
    v_fmac_f32 v98, v25, v85
    v_fmac_f32 v98, v26, v86
    v_fmac_f32 v98, v27, v87
    v_mul_f32 v98, v98, v88
    v_mul_f32 v99, v28, v84
    v_fmac_f32 v99, v29, v85
    v_fmac_f32 v99, v30, v86
    v_fmac_f32 v99, v31, v87
    v_mul_f32 v99, v99, v88
    v_cvt_pk_bf16_f32 v68, v92, v93
    v_lshlrev_b32 v10, 16, v68
    v_and_b32 v11, 0xffff0000, v68
    v_sub_f32 v10, v92, v10
    v_sub_f32 v11, v93, v11
    v_cvt_pk_bf16_f32 v72, v10, v11
    v_cvt_pk_bf16_f32 v69, v94, v95
    v_lshlrev_b32 v10, 16, v69
    v_and_b32 v11, 0xffff0000, v69
    v_sub_f32 v10, v94, v10
    v_sub_f32 v11, v95, v11
    v_cvt_pk_bf16_f32 v73, v10, v11
    v_cvt_pk_bf16_f32 v70, v96, v97
    v_lshlrev_b32 v10, 16, v70
    v_and_b32 v11, 0xffff0000, v70
    v_sub_f32 v10, v96, v10
    v_sub_f32 v11, v97, v11
    v_cvt_pk_bf16_f32 v74, v10, v11
    v_cvt_pk_bf16_f32 v71, v98, v99
    v_lshlrev_b32 v10, 16, v71
    v_and_b32 v11, 0xffff0000, v71
    v_sub_f32 v10, v98, v10
    v_sub_f32 v11, v99, v11
    v_cvt_pk_bf16_f32 v75, v10, v11
    s_waitcnt vmcnt(16)
    v_perm_b32 v64, v106, v104, s48
    v_perm_b32 v65, v110, v108, s48
    v_perm_b32 v66, v114, v112, s48
    v_perm_b32 v67, v118, v116, s48
    s_nop 1
    v_mfma_f32_16x16x32_bf16 v[48:51], v[68:71], v[64:67], v[48:51]
    v_mfma_f32_16x16x32_bf16 v[48:51], v[72:75], v[64:67], v[48:51]
    v_perm_b32 v64, v106, v104, s49
    v_perm_b32 v65, v110, v108, s49
    v_perm_b32 v66, v114, v112, s49
    v_perm_b32 v67, v118, v116, s49
    s_nop 1
    v_mfma_f32_16x16x32_bf16 v[52:55], v[68:71], v[64:67], v[52:55]
    v_mfma_f32_16x16x32_bf16 v[52:55], v[72:75], v[64:67], v[52:55]
    v_perm_b32 v64, v107, v105, s48
    v_perm_b32 v65, v111, v109, s48
    v_perm_b32 v66, v115, v113, s48
    v_perm_b32 v67, v119, v117, s48
    s_nop 1
    v_mfma_f32_16x16x32_bf16 v[56:59], v[68:71], v[64:67], v[56:59]
    v_mfma_f32_16x16x32_bf16 v[56:59], v[72:75], v[64:67], v[56:59]
    v_perm_b32 v64, v107, v105, s49
    v_perm_b32 v65, v111, v109, s49
    v_perm_b32 v66, v115, v113, s49
    v_perm_b32 v67, v119, v117, s49
    s_nop 1
    v_mfma_f32_16x16x32_bf16 v[60:63], v[68:71], v[64:67], v[60:63]
    v_mfma_f32_16x16x32_bf16 v[60:63], v[72:75], v[64:67], v[60:63]
    s_add_u32 s52, s64, 8
    s_cmp_lt_u32 s52, s65
    s_cbranch_scc1 nl_14
    s_nop 9
    v_mul_f32 v84, v32, v48
    v_fmac_f32 v84, v36, v49
    v_fmac_f32 v84, v40, v50
    v_fmac_f32 v84, v44, v51
    v_mul_f32 v85, v33, v52
    v_fmac_f32 v85, v37, v53
    v_fmac_f32 v85, v41, v54
    v_fmac_f32 v85, v45, v55
    v_mul_f32 v86, v34, v56
    v_fmac_f32 v86, v38, v57
    v_fmac_f32 v86, v42, v58
    v_fmac_f32 v86, v46, v59
    v_mul_f32 v87, v35, v60
    v_fmac_f32 v87, v39, v61
    v_fmac_f32 v87, v43, v62
    v_fmac_f32 v87, v47, v63
    s_cmp_eq_u32 s89, 1
    s_cbranch_scc1 f2_16
    s_lshl_b32 s52, s66, 10
    s_add_u32 s52, s52, s91
    v_lshlrev_b32 v10, 8, v6
    v_lshl_add_u32 v10, v5, 4, v10
    v_add_u32 v10, s52, v10
    s_cmp_eq_u32 s90, 0
    s_cbranch_scc1 f1_15
    buffer_load_dwordx4 v[88:91], v10, s[84:87], 0 offen sc1
    s_waitcnt vmcnt(0)
    v_add_f32 v84, v84, v88
    v_add_f32 v85, v85, v89
    v_add_f32 v86, v86, v90
    v_add_f32 v87, v87, v91
f1_15:
    s_add_u32 s52, s90, 1
    s_cmp_eq_u32 s52, s89
    s_cbranch_scc1 f2_16
    buffer_store_dwordx4 v[84:87], v10, s[84:87], 0 offen
    v_mov_b32 v48, 0
    v_mov_b32 v49, 0
    v_mov_b32 v50, 0
    v_mov_b32 v51, 0
    v_mov_b32 v52, 0
    v_mov_b32 v53, 0
    v_mov_b32 v54, 0
    v_mov_b32 v55, 0
    v_mov_b32 v56, 0
    v_mov_b32 v57, 0
    v_mov_b32 v58, 0
    v_mov_b32 v59, 0
    v_mov_b32 v60, 0
    v_mov_b32 v61, 0
    v_mov_b32 v62, 0
    v_mov_b32 v63, 0
    s_branch nl_14
f2_16:
    v_cvt_pk_bf16_f32 v88, v84, v85
    v_cvt_pk_bf16_f32 v89, v86, v87
    s_lshl_b32 s52, s59, 9
    s_add_u32 s52, s52, s79
    v_lshlrev_b32 v10, 7, v6
    v_add_u32 v10, v10, v1
    v_add_u32 v10, s52, v10
    ds_write_b64 v10, v[88:89]
    v_mov_b32 v48, 0
    v_mov_b32 v49, 0
    v_mov_b32 v50, 0
    v_mov_b32 v51, 0
    v_mov_b32 v52, 0
    v_mov_b32 v53, 0
    v_mov_b32 v54, 0
    v_mov_b32 v55, 0
    v_mov_b32 v56, 0
    v_mov_b32 v57, 0
    v_mov_b32 v58, 0
    v_mov_b32 v59, 0
    v_mov_b32 v60, 0
    v_mov_b32 v61, 0
    v_mov_b32 v62, 0
    v_mov_b32 v63, 0
    s_add_u32 s52, s66, s3
    s_mov_b32 m0, s59
    s_nop 0
    v_writelane_b32 v100, s52, m0
    s_add_u32 s59, s59, 1
    s_cmp_lt_u32 s59, 4
    s_cbranch_scc1 nl_14
    v_lshlrev_b32 v10, 7, v5
    v_lshl_add_u32 v10, v6, 4, v10
    v_add_u32 v10, s79, v10
    ds_read_b128 v[84:87], v10
    ds_read_b128 v[88:91], v10 offset:64
    v_lshlrev_b32 v11, 4, v4
    ds_read_b128 v[64:67], v11 offset:8192
    ds_read_b128 v[76:79], v11 offset:9216
    s_waitcnt lgkmcnt(0)
    v_mfma_f32_16x16x32_bf16 v[68:71], v[64:67], v[84:87], 0
    v_mfma_f32_16x16x32_bf16 v[68:71], v[76:79], v[88:91], v[68:71]
    s_nop 9
    v_cvt_pk_bf16_f32 v92, v68, v69
    v_cvt_pk_bf16_f32 v93, v70, v71
    ds_read_b128 v[64:67], v11 offset:10240
    ds_read_b128 v[76:79], v11 offset:11264
    s_waitcnt lgkmcnt(0)
    v_mfma_f32_16x16x32_bf16 v[68:71], v[64:67], v[84:87], 0
    v_mfma_f32_16x16x32_bf16 v[68:71], v[76:79], v[88:91], v[68:71]
    s_nop 9
    v_cvt_pk_bf16_f32 v94, v68, v69
    v_cvt_pk_bf16_f32 v95, v70, v71
    ds_read_b128 v[64:67], v11 offset:12288
    ds_read_b128 v[76:79], v11 offset:13312
    s_waitcnt lgkmcnt(0)
    v_mfma_f32_16x16x32_bf16 v[68:71], v[64:67], v[84:87], 0
    v_mfma_f32_16x16x32_bf16 v[68:71], v[76:79], v[88:91], v[68:71]
    s_nop 9
    v_cvt_pk_bf16_f32 v96, v68, v69
    v_cvt_pk_bf16_f32 v97, v70, v71
    ds_read_b128 v[64:67], v11 offset:14336
    ds_read_b128 v[76:79], v11 offset:15360
    s_waitcnt lgkmcnt(0)
    v_mfma_f32_16x16x32_bf16 v[68:71], v[64:67], v[84:87], 0
    v_mfma_f32_16x16x32_bf16 v[68:71], v[76:79], v[88:91], v[68:71]
    s_nop 9
    v_cvt_pk_bf16_f32 v98, v68, v69
    v_cvt_pk_bf16_f32 v99, v70, v71
    v_lshrrev_b32 v10, 2, v5
    v_lshlrev_b32 v10, 2, v10
    ds_bpermute_b32 v10, v10, v100
    v_and_b32 v11, 3, v5
    v_lshlrev_b32 v11, 7, v11
    v_lshl_add_u32 v11, v6, 5, v11
    s_waitcnt lgkmcnt(0)
    v_cmp_gt_u32 vcc, 0x10000, v10
    v_lshl_add_u32 v10, v10, 9, v11
    s_nop 0
    v_cndmask_b32 v10, v101, v10, vcc
    buffer_store_dwordx4 v[92:95], v10, s[20:23], 0 offen
    buffer_store_dwordx4 v[96:99], v10, s[20:23], 0 offen offset:16
    s_nop 1
    v_mov_b32 v100, -1
    s_mov_b32 s59, 0
nl_14:
    s_cmp_lt_u32 s56, s57
    s_cbranch_scc1 nh_17
    s_mov_b64 exec, 1
    v_mov_b32 v10, 0
    ds_add_rtn_u32 v10, v10, v102 offset:4096
    s_waitcnt lgkmcnt(0)
    v_readfirstlane_b32 s58, v10
    s_mov_b64 exec, -1
    s_cmp_ge_u32 s58, s60
    s_cbranch_scc1 nd_18
    s_lshl_b32 s52, s58, 2
    v_mov_b32 v10, s52
    v_add_u32 v12, 0, v10
    ds_read2_b32 v[10:11], v12 offset0:0 offset1:1
    s_waitcnt lgkmcnt(0)
    v_readfirstlane_b32 s56, v10
    v_readfirstlane_b32 s57, v11
    s_branch nh_17
nd_18:
    s_mov_b32 s58, -1
    s_mov_b32 s56, 0
    s_mov_b32 s57, 0
nh_17:
    s_mov_b32 s64, s56
    s_mov_b32 s65, s57
    s_mov_b32 s66, s58
    s_add_u32 s56, s56, 8
    v_add_u32 v10, s64, v2
    v_lshlrev_b32 v11, 2, v10
    v_add_u32 v11, 32768, v11
    ds_read2_b32 v[12:13], v11 offset0:0 offset1:1
    v_add_u32 v11, 1, v10
    v_cmp_gt_u32 vcc, s65, v10
    v_cmp_gt_u32 s[54:55], s65, v11
    s_waitcnt lgkmcnt(0)
    v_lshl_add_u32 v12, v12, 9, v1
    v_lshl_add_u32 v13, v13, 9, v1
    v_cndmask_b32 v12, v101, v12, vcc
    v_cndmask_b32 v13, v101, v13, s[54:55]
    buffer_load_dwordx2 v[104:105], v12, s[16:19], 0 offen offset:0
    buffer_load_dwordx2 v[106:107], v12, s[16:19], 0 offen offset:128
    buffer_load_dwordx2 v[108:109], v12, s[16:19], 0 offen offset:256
    buffer_load_dwordx2 v[110:111], v12, s[16:19], 0 offen offset:384
    buffer_load_dwordx2 v[112:113], v13, s[16:19], 0 offen offset:0
    buffer_load_dwordx2 v[114:115], v13, s[16:19], 0 offen offset:128
    buffer_load_dwordx2 v[116:117], v13, s[16:19], 0 offen offset:256
    buffer_load_dwordx2 v[118:119], v13, s[16:19], 0 offen offset:384
    s_cmp_eq_u32 s69, -1
    s_cbranch_scc1 B_done
    v_add_u32 v10, s67, v2
    v_lshlrev_b32 v11, 4, v10
    ds_read_b128 v[76:79], v11 offset:49152
    ds_read_b128 v[80:83], v11 offset:49168
    v_add_u32 v11, 1, v10
    v_cmp_gt_u32 vcc, s68, v10
    v_cmp_gt_u32 s[54:55], s68, v11
    s_waitcnt lgkmcnt(0)
    v_lshlrev_b32 v84, 16, v76
    v_and_b32 v85, 0xffff0000, v76
    v_lshlrev_b32 v86, 16, v77
    v_and_b32 v87, 0xffff0000, v77
    v_cndmask_b32 v88, v78, v79, s[62:63]
    v_lshlrev_b32 v88, v3, v88
    v_and_b32 v88, 0xffff0000, v88
    v_cndmask_b32 v88, 0, v88, vcc
    v_mul_f32 v92, v16, v84
    v_fmac_f32 v92, v17, v85
    v_fmac_f32 v92, v18, v86
    v_fmac_f32 v92, v19, v87
    v_mul_f32 v92, v92, v88
    v_mul_f32 v93, v20, v84
    v_fmac_f32 v93, v21, v85
    v_fmac_f32 v93, v22, v86
    v_fmac_f32 v93, v23, v87
    v_mul_f32 v93, v93, v88
    v_mul_f32 v94, v24, v84
    v_fmac_f32 v94, v25, v85
    v_fmac_f32 v94, v26, v86
    v_fmac_f32 v94, v27, v87
    v_mul_f32 v94, v94, v88
    v_mul_f32 v95, v28, v84
    v_fmac_f32 v95, v29, v85
    v_fmac_f32 v95, v30, v86
    v_fmac_f32 v95, v31, v87
    v_mul_f32 v95, v95, v88
    v_lshlrev_b32 v84, 16, v80
    v_and_b32 v85, 0xffff0000, v80
    v_lshlrev_b32 v86, 16, v81
    v_and_b32 v87, 0xffff0000, v81
    v_cndmask_b32 v88, v82, v83, s[62:63]
    v_lshlrev_b32 v88, v3, v88
    v_and_b32 v88, 0xffff0000, v88
    v_cndmask_b32 v88, 0, v88, s[54:55]
    v_mul_f32 v96, v16, v84
    v_fmac_f32 v96, v17, v85
    v_fmac_f32 v96, v18, v86
    v_fmac_f32 v96, v19, v87
    v_mul_f32 v96, v96, v88
    v_mul_f32 v97, v20, v84
    v_fmac_f32 v97, v21, v85
    v_fmac_f32 v97, v22, v86
    v_fmac_f32 v97, v23, v87
    v_mul_f32 v97, v97, v88
    v_mul_f32 v98, v24, v84
    v_fmac_f32 v98, v25, v85
    v_fmac_f32 v98, v26, v86
    v_fmac_f32 v98, v27, v87
    v_mul_f32 v98, v98, v88
    v_mul_f32 v99, v28, v84
    v_fmac_f32 v99, v29, v85
    v_fmac_f32 v99, v30, v86
    v_fmac_f32 v99, v31, v87
    v_mul_f32 v99, v99, v88
    v_cvt_pk_bf16_f32 v68, v92, v93
    v_lshlrev_b32 v10, 16, v68
    v_and_b32 v11, 0xffff0000, v68
    v_sub_f32 v10, v92, v10
    v_sub_f32 v11, v93, v11
    v_cvt_pk_bf16_f32 v72, v10, v11
    v_cvt_pk_bf16_f32 v69, v94, v95
    v_lshlrev_b32 v10, 16, v69
    v_and_b32 v11, 0xffff0000, v69
    v_sub_f32 v10, v94, v10
    v_sub_f32 v11, v95, v11
    v_cvt_pk_bf16_f32 v73, v10, v11
    v_cvt_pk_bf16_f32 v70, v96, v97
    v_lshlrev_b32 v10, 16, v70
    v_and_b32 v11, 0xffff0000, v70
    v_sub_f32 v10, v96, v10
    v_sub_f32 v11, v97, v11
    v_cvt_pk_bf16_f32 v74, v10, v11
    v_cvt_pk_bf16_f32 v71, v98, v99
    v_lshlrev_b32 v10, 16, v71
    v_and_b32 v11, 0xffff0000, v71
    v_sub_f32 v10, v98, v10
    v_sub_f32 v11, v99, v11
    v_cvt_pk_bf16_f32 v75, v10, v11
    s_waitcnt vmcnt(16)
    v_perm_b32 v64, v122, v120, s48
    v_perm_b32 v65, v126, v124, s48
    v_perm_b32 v66, v130, v128, s48
    v_perm_b32 v67, v134, v132, s48
    s_nop 1
    v_mfma_f32_16x16x32_bf16 v[48:51], v[68:71], v[64:67], v[48:51]
    v_mfma_f32_16x16x32_bf16 v[48:51], v[72:75], v[64:67], v[48:51]
    v_perm_b32 v64, v122, v120, s49
    v_perm_b32 v65, v126, v124, s49
    v_perm_b32 v66, v130, v128, s49
    v_perm_b32 v67, v134, v132, s49
    s_nop 1
    v_mfma_f32_16x16x32_bf16 v[52:55], v[68:71], v[64:67], v[52:55]
    v_mfma_f32_16x16x32_bf16 v[52:55], v[72:75], v[64:67], v[52:55]
    v_perm_b32 v64, v123, v121, s48
    v_perm_b32 v65, v127, v125, s48
    v_perm_b32 v66, v131, v129, s48
    v_perm_b32 v67, v135, v133, s48
    s_nop 1
    v_mfma_f32_16x16x32_bf16 v[56:59], v[68:71], v[64:67], v[56:59]
    v_mfma_f32_16x16x32_bf16 v[56:59], v[72:75], v[64:67], v[56:59]
    v_perm_b32 v64, v123, v121, s49
    v_perm_b32 v65, v127, v125, s49
    v_perm_b32 v66, v131, v129, s49
    v_perm_b32 v67, v135, v133, s49
    s_nop 1
    v_mfma_f32_16x16x32_bf16 v[60:63], v[68:71], v[64:67], v[60:63]
    v_mfma_f32_16x16x32_bf16 v[60:63], v[72:75], v[64:67], v[60:63]
    s_add_u32 s52, s67, 8
    s_cmp_lt_u32 s52, s68
    s_cbranch_scc1 nl_20
    s_nop 9
    v_mul_f32 v84, v32, v48
    v_fmac_f32 v84, v36, v49
    v_fmac_f32 v84, v40, v50
    v_fmac_f32 v84, v44, v51
    v_mul_f32 v85, v33, v52
    v_fmac_f32 v85, v37, v53
    v_fmac_f32 v85, v41, v54
    v_fmac_f32 v85, v45, v55
    v_mul_f32 v86, v34, v56
    v_fmac_f32 v86, v38, v57
    v_fmac_f32 v86, v42, v58
    v_fmac_f32 v86, v46, v59
    v_mul_f32 v87, v35, v60
    v_fmac_f32 v87, v39, v61
    v_fmac_f32 v87, v43, v62
    v_fmac_f32 v87, v47, v63
    s_cmp_eq_u32 s89, 1
    s_cbranch_scc1 f2_22
    s_lshl_b32 s52, s69, 10
    s_add_u32 s52, s52, s91
    v_lshlrev_b32 v10, 8, v6
    v_lshl_add_u32 v10, v5, 4, v10
    v_add_u32 v10, s52, v10
    s_cmp_eq_u32 s90, 0
    s_cbranch_scc1 f1_21
    buffer_load_dwordx4 v[88:91], v10, s[84:87], 0 offen sc1
    s_waitcnt vmcnt(0)
    v_add_f32 v84, v84, v88
    v_add_f32 v85, v85, v89
    v_add_f32 v86, v86, v90
    v_add_f32 v87, v87, v91
f1_21:
    s_add_u32 s52, s90, 1
    s_cmp_eq_u32 s52, s89
    s_cbranch_scc1 f2_22
    buffer_store_dwordx4 v[84:87], v10, s[84:87], 0 offen
    v_mov_b32 v48, 0
    v_mov_b32 v49, 0
    v_mov_b32 v50, 0
    v_mov_b32 v51, 0
    v_mov_b32 v52, 0
    v_mov_b32 v53, 0
    v_mov_b32 v54, 0
    v_mov_b32 v55, 0
    v_mov_b32 v56, 0
    v_mov_b32 v57, 0
    v_mov_b32 v58, 0
    v_mov_b32 v59, 0
    v_mov_b32 v60, 0
    v_mov_b32 v61, 0
    v_mov_b32 v62, 0
    v_mov_b32 v63, 0
    s_branch nl_20
f2_22:
    v_cvt_pk_bf16_f32 v88, v84, v85
    v_cvt_pk_bf16_f32 v89, v86, v87
    s_lshl_b32 s52, s59, 9
    s_add_u32 s52, s52, s79
    v_lshlrev_b32 v10, 7, v6
    v_add_u32 v10, v10, v1
    v_add_u32 v10, s52, v10
    ds_write_b64 v10, v[88:89]
    v_mov_b32 v48, 0
    v_mov_b32 v49, 0
    v_mov_b32 v50, 0
    v_mov_b32 v51, 0
    v_mov_b32 v52, 0
    v_mov_b32 v53, 0
    v_mov_b32 v54, 0
    v_mov_b32 v55, 0
    v_mov_b32 v56, 0
    v_mov_b32 v57, 0
    v_mov_b32 v58, 0
    v_mov_b32 v59, 0
    v_mov_b32 v60, 0
    v_mov_b32 v61, 0
    v_mov_b32 v62, 0
    v_mov_b32 v63, 0
    s_add_u32 s52, s69, s3
    s_mov_b32 m0, s59
    s_nop 0
    v_writelane_b32 v100, s52, m0
    s_add_u32 s59, s59, 1
    s_cmp_lt_u32 s59, 4
    s_cbranch_scc1 nl_20
    v_lshlrev_b32 v10, 7, v5
    v_lshl_add_u32 v10, v6, 4, v10
    v_add_u32 v10, s79, v10
    ds_read_b128 v[84:87], v10
    ds_read_b128 v[88:91], v10 offset:64
    v_lshlrev_b32 v11, 4, v4
    ds_read_b128 v[64:67], v11 offset:8192
    ds_read_b128 v[76:79], v11 offset:9216
    s_waitcnt lgkmcnt(0)
    v_mfma_f32_16x16x32_bf16 v[68:71], v[64:67], v[84:87], 0
    v_mfma_f32_16x16x32_bf16 v[68:71], v[76:79], v[88:91], v[68:71]
    s_nop 9
    v_cvt_pk_bf16_f32 v92, v68, v69
    v_cvt_pk_bf16_f32 v93, v70, v71
    ds_read_b128 v[64:67], v11 offset:10240
    ds_read_b128 v[76:79], v11 offset:11264
    s_waitcnt lgkmcnt(0)
    v_mfma_f32_16x16x32_bf16 v[68:71], v[64:67], v[84:87], 0
    v_mfma_f32_16x16x32_bf16 v[68:71], v[76:79], v[88:91], v[68:71]
    s_nop 9
    v_cvt_pk_bf16_f32 v94, v68, v69
    v_cvt_pk_bf16_f32 v95, v70, v71
    ds_read_b128 v[64:67], v11 offset:12288
    ds_read_b128 v[76:79], v11 offset:13312
    s_waitcnt lgkmcnt(0)
    v_mfma_f32_16x16x32_bf16 v[68:71], v[64:67], v[84:87], 0
    v_mfma_f32_16x16x32_bf16 v[68:71], v[76:79], v[88:91], v[68:71]
    s_nop 9
    v_cvt_pk_bf16_f32 v96, v68, v69
    v_cvt_pk_bf16_f32 v97, v70, v71
    ds_read_b128 v[64:67], v11 offset:14336
    ds_read_b128 v[76:79], v11 offset:15360
    s_waitcnt lgkmcnt(0)
    v_mfma_f32_16x16x32_bf16 v[68:71], v[64:67], v[84:87], 0
    v_mfma_f32_16x16x32_bf16 v[68:71], v[76:79], v[88:91], v[68:71]
    s_nop 9
    v_cvt_pk_bf16_f32 v98, v68, v69
    v_cvt_pk_bf16_f32 v99, v70, v71
    v_lshrrev_b32 v10, 2, v5
    v_lshlrev_b32 v10, 2, v10
    ds_bpermute_b32 v10, v10, v100
    v_and_b32 v11, 3, v5
    v_lshlrev_b32 v11, 7, v11
    v_lshl_add_u32 v11, v6, 5, v11
    s_waitcnt lgkmcnt(0)
    v_cmp_gt_u32 vcc, 0x10000, v10
    v_lshl_add_u32 v10, v10, 9, v11
    s_nop 0
    v_cndmask_b32 v10, v101, v10, vcc
    buffer_store_dwordx4 v[92:95], v10, s[20:23], 0 offen
    buffer_store_dwordx4 v[96:99], v10, s[20:23], 0 offen offset:16
    s_nop 1
    v_mov_b32 v100, -1
    s_mov_b32 s59, 0
nl_20:
    s_cmp_lt_u32 s56, s57
    s_cbranch_scc1 nh_23
    s_mov_b64 exec, 1
    v_mov_b32 v10, 0
    ds_add_rtn_u32 v10, v10, v102 offset:4096
    s_waitcnt lgkmcnt(0)
    v_readfirstlane_b32 s58, v10
    s_mov_b64 exec, -1
    s_cmp_ge_u32 s58, s60
    s_cbranch_scc1 nd_24
    s_lshl_b32 s52, s58, 2
    v_mov_b32 v10, s52
    v_add_u32 v12, 0, v10
    ds_read2_b32 v[10:11], v12 offset0:0 offset1:1
    s_waitcnt lgkmcnt(0)
    v_readfirstlane_b32 s56, v10
    v_readfirstlane_b32 s57, v11
    s_branch nh_23
nd_24:
    s_mov_b32 s58, -1
    s_mov_b32 s56, 0
    s_mov_b32 s57, 0
nh_23:
    s_mov_b32 s67, s56
    s_mov_b32 s68, s57
    s_mov_b32 s69, s58
    s_add_u32 s56, s56, 8
    v_add_u32 v10, s67, v2
    v_lshlrev_b32 v11, 2, v10
    v_add_u32 v11, 32768, v11
    ds_read2_b32 v[12:13], v11 offset0:0 offset1:1
    v_add_u32 v11, 1, v10
    v_cmp_gt_u32 vcc, s68, v10
    v_cmp_gt_u32 s[54:55], s68, v11
    s_waitcnt lgkmcnt(0)
    v_lshl_add_u32 v12, v12, 9, v1
    v_lshl_add_u32 v13, v13, 9, v1
    v_cndmask_b32 v12, v101, v12, vcc
    v_cndmask_b32 v13, v101, v13, s[54:55]
    buffer_load_dwordx2 v[120:121], v12, s[16:19], 0 offen offset:0
    buffer_load_dwordx2 v[122:123], v12, s[16:19], 0 offen offset:128
    buffer_load_dwordx2 v[124:125], v12, s[16:19], 0 offen offset:256
    buffer_load_dwordx2 v[126:127], v12, s[16:19], 0 offen offset:384
    buffer_load_dwordx2 v[128:129], v13, s[16:19], 0 offen offset:0
    buffer_load_dwordx2 v[130:131], v13, s[16:19], 0 offen offset:128
    buffer_load_dwordx2 v[132:133], v13, s[16:19], 0 offen offset:256
    buffer_load_dwordx2 v[134:135], v13, s[16:19], 0 offen offset:384
    s_cmp_eq_u32 s72, -1
    s_cbranch_scc1 B_done
    v_add_u32 v10, s70, v2
    v_lshlrev_b32 v11, 4, v10
    ds_read_b128 v[76:79], v11 offset:49152
    ds_read_b128 v[80:83], v11 offset:49168
    v_add_u32 v11, 1, v10
    v_cmp_gt_u32 vcc, s71, v10
    v_cmp_gt_u32 s[54:55], s71, v11
    s_waitcnt lgkmcnt(0)
    v_lshlrev_b32 v84, 16, v76
    v_and_b32 v85, 0xffff0000, v76
    v_lshlrev_b32 v86, 16, v77
    v_and_b32 v87, 0xffff0000, v77
    v_cndmask_b32 v88, v78, v79, s[62:63]
    v_lshlrev_b32 v88, v3, v88
    v_and_b32 v88, 0xffff0000, v88
    v_cndmask_b32 v88, 0, v88, vcc
    v_mul_f32 v92, v16, v84
    v_fmac_f32 v92, v17, v85
    v_fmac_f32 v92, v18, v86
    v_fmac_f32 v92, v19, v87
    v_mul_f32 v92, v92, v88
    v_mul_f32 v93, v20, v84
    v_fmac_f32 v93, v21, v85
    v_fmac_f32 v93, v22, v86
    v_fmac_f32 v93, v23, v87
    v_mul_f32 v93, v93, v88
    v_mul_f32 v94, v24, v84
    v_fmac_f32 v94, v25, v85
    v_fmac_f32 v94, v26, v86
    v_fmac_f32 v94, v27, v87
    v_mul_f32 v94, v94, v88
    v_mul_f32 v95, v28, v84
    v_fmac_f32 v95, v29, v85
    v_fmac_f32 v95, v30, v86
    v_fmac_f32 v95, v31, v87
    v_mul_f32 v95, v95, v88
    v_lshlrev_b32 v84, 16, v80
    v_and_b32 v85, 0xffff0000, v80
    v_lshlrev_b32 v86, 16, v81
    v_and_b32 v87, 0xffff0000, v81
    v_cndmask_b32 v88, v82, v83, s[62:63]
    v_lshlrev_b32 v88, v3, v88
    v_and_b32 v88, 0xffff0000, v88
    v_cndmask_b32 v88, 0, v88, s[54:55]
    v_mul_f32 v96, v16, v84
    v_fmac_f32 v96, v17, v85
    v_fmac_f32 v96, v18, v86
    v_fmac_f32 v96, v19, v87
    v_mul_f32 v96, v96, v88
    v_mul_f32 v97, v20, v84
    v_fmac_f32 v97, v21, v85
    v_fmac_f32 v97, v22, v86
    v_fmac_f32 v97, v23, v87
    v_mul_f32 v97, v97, v88
    v_mul_f32 v98, v24, v84
    v_fmac_f32 v98, v25, v85
    v_fmac_f32 v98, v26, v86
    v_fmac_f32 v98, v27, v87
    v_mul_f32 v98, v98, v88
    v_mul_f32 v99, v28, v84
    v_fmac_f32 v99, v29, v85
    v_fmac_f32 v99, v30, v86
    v_fmac_f32 v99, v31, v87
    v_mul_f32 v99, v99, v88
    v_cvt_pk_bf16_f32 v68, v92, v93
    v_lshlrev_b32 v10, 16, v68
    v_and_b32 v11, 0xffff0000, v68
    v_sub_f32 v10, v92, v10
    v_sub_f32 v11, v93, v11
    v_cvt_pk_bf16_f32 v72, v10, v11
    v_cvt_pk_bf16_f32 v69, v94, v95
    v_lshlrev_b32 v10, 16, v69
    v_and_b32 v11, 0xffff0000, v69
    v_sub_f32 v10, v94, v10
    v_sub_f32 v11, v95, v11
    v_cvt_pk_bf16_f32 v73, v10, v11
    v_cvt_pk_bf16_f32 v70, v96, v97
    v_lshlrev_b32 v10, 16, v70
    v_and_b32 v11, 0xffff0000, v70
    v_sub_f32 v10, v96, v10
    v_sub_f32 v11, v97, v11
    v_cvt_pk_bf16_f32 v74, v10, v11
    v_cvt_pk_bf16_f32 v71, v98, v99
    v_lshlrev_b32 v10, 16, v71
    v_and_b32 v11, 0xffff0000, v71
    v_sub_f32 v10, v98, v10
    v_sub_f32 v11, v99, v11
    v_cvt_pk_bf16_f32 v75, v10, v11
    s_waitcnt vmcnt(16)
    v_perm_b32 v64, v138, v136, s48
    v_perm_b32 v65, v142, v140, s48
    v_perm_b32 v66, v146, v144, s48
    v_perm_b32 v67, v150, v148, s48
    s_nop 1
    v_mfma_f32_16x16x32_bf16 v[48:51], v[68:71], v[64:67], v[48:51]
    v_mfma_f32_16x16x32_bf16 v[48:51], v[72:75], v[64:67], v[48:51]
    v_perm_b32 v64, v138, v136, s49
    v_perm_b32 v65, v142, v140, s49
    v_perm_b32 v66, v146, v144, s49
    v_perm_b32 v67, v150, v148, s49
    s_nop 1
    v_mfma_f32_16x16x32_bf16 v[52:55], v[68:71], v[64:67], v[52:55]
    v_mfma_f32_16x16x32_bf16 v[52:55], v[72:75], v[64:67], v[52:55]
    v_perm_b32 v64, v139, v137, s48
    v_perm_b32 v65, v143, v141, s48
    v_perm_b32 v66, v147, v145, s48
    v_perm_b32 v67, v151, v149, s48
    s_nop 1
    v_mfma_f32_16x16x32_bf16 v[56:59], v[68:71], v[64:67], v[56:59]
    v_mfma_f32_16x16x32_bf16 v[56:59], v[72:75], v[64:67], v[56:59]
    v_perm_b32 v64, v139, v137, s49
    v_perm_b32 v65, v143, v141, s49
    v_perm_b32 v66, v147, v145, s49
    v_perm_b32 v67, v151, v149, s49
    s_nop 1
    v_mfma_f32_16x16x32_bf16 v[60:63], v[68:71], v[64:67], v[60:63]
    v_mfma_f32_16x16x32_bf16 v[60:63], v[72:75], v[64:67], v[60:63]
    s_add_u32 s52, s70, 8
    s_cmp_lt_u32 s52, s71
    s_cbranch_scc1 nl_26
    s_nop 9
    v_mul_f32 v84, v32, v48
    v_fmac_f32 v84, v36, v49
    v_fmac_f32 v84, v40, v50
    v_fmac_f32 v84, v44, v51
    v_mul_f32 v85, v33, v52
    v_fmac_f32 v85, v37, v53
    v_fmac_f32 v85, v41, v54
    v_fmac_f32 v85, v45, v55
    v_mul_f32 v86, v34, v56
    v_fmac_f32 v86, v38, v57
    v_fmac_f32 v86, v42, v58
    v_fmac_f32 v86, v46, v59
    v_mul_f32 v87, v35, v60
    v_fmac_f32 v87, v39, v61
    v_fmac_f32 v87, v43, v62
    v_fmac_f32 v87, v47, v63
    s_cmp_eq_u32 s89, 1
    s_cbranch_scc1 f2_28
    s_lshl_b32 s52, s72, 10
    s_add_u32 s52, s52, s91
    v_lshlrev_b32 v10, 8, v6
    v_lshl_add_u32 v10, v5, 4, v10
    v_add_u32 v10, s52, v10
    s_cmp_eq_u32 s90, 0
    s_cbranch_scc1 f1_27
    buffer_load_dwordx4 v[88:91], v10, s[84:87], 0 offen sc1
    s_waitcnt vmcnt(0)
    v_add_f32 v84, v84, v88
    v_add_f32 v85, v85, v89
    v_add_f32 v86, v86, v90
    v_add_f32 v87, v87, v91
f1_27:
    s_add_u32 s52, s90, 1
    s_cmp_eq_u32 s52, s89
    s_cbranch_scc1 f2_28
    buffer_store_dwordx4 v[84:87], v10, s[84:87], 0 offen
    v_mov_b32 v48, 0
    v_mov_b32 v49, 0
    v_mov_b32 v50, 0
    v_mov_b32 v51, 0
    v_mov_b32 v52, 0
    v_mov_b32 v53, 0
    v_mov_b32 v54, 0
    v_mov_b32 v55, 0
    v_mov_b32 v56, 0
    v_mov_b32 v57, 0
    v_mov_b32 v58, 0
    v_mov_b32 v59, 0
    v_mov_b32 v60, 0
    v_mov_b32 v61, 0
    v_mov_b32 v62, 0
    v_mov_b32 v63, 0
    s_branch nl_26
f2_28:
    v_cvt_pk_bf16_f32 v88, v84, v85
    v_cvt_pk_bf16_f32 v89, v86, v87
    s_lshl_b32 s52, s59, 9
    s_add_u32 s52, s52, s79
    v_lshlrev_b32 v10, 7, v6
    v_add_u32 v10, v10, v1
    v_add_u32 v10, s52, v10
    ds_write_b64 v10, v[88:89]
    v_mov_b32 v48, 0
    v_mov_b32 v49, 0
    v_mov_b32 v50, 0
    v_mov_b32 v51, 0
    v_mov_b32 v52, 0
    v_mov_b32 v53, 0
    v_mov_b32 v54, 0
    v_mov_b32 v55, 0
    v_mov_b32 v56, 0
    v_mov_b32 v57, 0
    v_mov_b32 v58, 0
    v_mov_b32 v59, 0
    v_mov_b32 v60, 0
    v_mov_b32 v61, 0
    v_mov_b32 v62, 0
    v_mov_b32 v63, 0
    s_add_u32 s52, s72, s3
    s_mov_b32 m0, s59
    s_nop 0
    v_writelane_b32 v100, s52, m0
    s_add_u32 s59, s59, 1
    s_cmp_lt_u32 s59, 4
    s_cbranch_scc1 nl_26
    v_lshlrev_b32 v10, 7, v5
    v_lshl_add_u32 v10, v6, 4, v10
    v_add_u32 v10, s79, v10
    ds_read_b128 v[84:87], v10
    ds_read_b128 v[88:91], v10 offset:64
    v_lshlrev_b32 v11, 4, v4
    ds_read_b128 v[64:67], v11 offset:8192
    ds_read_b128 v[76:79], v11 offset:9216
    s_waitcnt lgkmcnt(0)
    v_mfma_f32_16x16x32_bf16 v[68:71], v[64:67], v[84:87], 0
    v_mfma_f32_16x16x32_bf16 v[68:71], v[76:79], v[88:91], v[68:71]
    s_nop 9
    v_cvt_pk_bf16_f32 v92, v68, v69
    v_cvt_pk_bf16_f32 v93, v70, v71
    ds_read_b128 v[64:67], v11 offset:10240
    ds_read_b128 v[76:79], v11 offset:11264
    s_waitcnt lgkmcnt(0)
    v_mfma_f32_16x16x32_bf16 v[68:71], v[64:67], v[84:87], 0
    v_mfma_f32_16x16x32_bf16 v[68:71], v[76:79], v[88:91], v[68:71]
    s_nop 9
    v_cvt_pk_bf16_f32 v94, v68, v69
    v_cvt_pk_bf16_f32 v95, v70, v71
    ds_read_b128 v[64:67], v11 offset:12288
    ds_read_b128 v[76:79], v11 offset:13312
    s_waitcnt lgkmcnt(0)
    v_mfma_f32_16x16x32_bf16 v[68:71], v[64:67], v[84:87], 0
    v_mfma_f32_16x16x32_bf16 v[68:71], v[76:79], v[88:91], v[68:71]
    s_nop 9
    v_cvt_pk_bf16_f32 v96, v68, v69
    v_cvt_pk_bf16_f32 v97, v70, v71
    ds_read_b128 v[64:67], v11 offset:14336
    ds_read_b128 v[76:79], v11 offset:15360
    s_waitcnt lgkmcnt(0)
    v_mfma_f32_16x16x32_bf16 v[68:71], v[64:67], v[84:87], 0
    v_mfma_f32_16x16x32_bf16 v[68:71], v[76:79], v[88:91], v[68:71]
    s_nop 9
    v_cvt_pk_bf16_f32 v98, v68, v69
    v_cvt_pk_bf16_f32 v99, v70, v71
    v_lshrrev_b32 v10, 2, v5
    v_lshlrev_b32 v10, 2, v10
    ds_bpermute_b32 v10, v10, v100
    v_and_b32 v11, 3, v5
    v_lshlrev_b32 v11, 7, v11
    v_lshl_add_u32 v11, v6, 5, v11
    s_waitcnt lgkmcnt(0)
    v_cmp_gt_u32 vcc, 0x10000, v10
    v_lshl_add_u32 v10, v10, 9, v11
    s_nop 0
    v_cndmask_b32 v10, v101, v10, vcc
    buffer_store_dwordx4 v[92:95], v10, s[20:23], 0 offen
    buffer_store_dwordx4 v[96:99], v10, s[20:23], 0 offen offset:16
    s_nop 1
    v_mov_b32 v100, -1
    s_mov_b32 s59, 0
nl_26:
    s_branch B_loop
B_done:
    s_cmp_eq_u32 s59, 0
    s_cbranch_scc1 B_nf
    v_lshlrev_b32 v10, 7, v5
    v_lshl_add_u32 v10, v6, 4, v10
    v_add_u32 v10, s79, v10
    ds_read_b128 v[84:87], v10
    ds_read_b128 v[88:91], v10 offset:64
    v_lshlrev_b32 v11, 4, v4
    ds_read_b128 v[64:67], v11 offset:8192
    ds_read_b128 v[76:79], v11 offset:9216
    s_waitcnt lgkmcnt(0)
    v_mfma_f32_16x16x32_bf16 v[68:71], v[64:67], v[84:87], 0
    v_mfma_f32_16x16x32_bf16 v[68:71], v[76:79], v[88:91], v[68:71]
    s_nop 9
    v_cvt_pk_bf16_f32 v92, v68, v69
    v_cvt_pk_bf16_f32 v93, v70, v71
    ds_read_b128 v[64:67], v11 offset:10240
    ds_read_b128 v[76:79], v11 offset:11264
    s_waitcnt lgkmcnt(0)
    v_mfma_f32_16x16x32_bf16 v[68:71], v[64:67], v[84:87], 0
    v_mfma_f32_16x16x32_bf16 v[68:71], v[76:79], v[88:91], v[68:71]
    s_nop 9
    v_cvt_pk_bf16_f32 v94, v68, v69
    v_cvt_pk_bf16_f32 v95, v70, v71
    ds_read_b128 v[64:67], v11 offset:12288
    ds_read_b128 v[76:79], v11 offset:13312
    s_waitcnt lgkmcnt(0)
    v_mfma_f32_16x16x32_bf16 v[68:71], v[64:67], v[84:87], 0
    v_mfma_f32_16x16x32_bf16 v[68:71], v[76:79], v[88:91], v[68:71]
    s_nop 9
    v_cvt_pk_bf16_f32 v96, v68, v69
    v_cvt_pk_bf16_f32 v97, v70, v71
    ds_read_b128 v[64:67], v11 offset:14336
    ds_read_b128 v[76:79], v11 offset:15360
    s_waitcnt lgkmcnt(0)
    v_mfma_f32_16x16x32_bf16 v[68:71], v[64:67], v[84:87], 0
    v_mfma_f32_16x16x32_bf16 v[68:71], v[76:79], v[88:91], v[68:71]
    s_nop 9
    v_cvt_pk_bf16_f32 v98, v68, v69
    v_cvt_pk_bf16_f32 v99, v70, v71
    v_lshrrev_b32 v10, 2, v5
    v_lshlrev_b32 v10, 2, v10
    ds_bpermute_b32 v10, v10, v100
    v_and_b32 v11, 3, v5
    v_lshlrev_b32 v11, 7, v11
    v_lshl_add_u32 v11, v6, 5, v11
    s_waitcnt lgkmcnt(0)
    v_cmp_gt_u32 vcc, 0x10000, v10
    v_lshl_add_u32 v10, v10, 9, v11
    s_nop 0
    v_cndmask_b32 v10, v101, v10, vcc
    buffer_store_dwordx4 v[92:95], v10, s[20:23], 0 offen
    buffer_store_dwordx4 v[96:99], v10, s[20:23], 0 offen offset:16
    s_nop 1
    v_mov_b32 v100, -1
    s_mov_b32 s59, 0
B_nf:
    s_add_u32 s90, s90, 1
    s_cmp_ge_u32 s90, s89
    s_cbranch_scc1 B_end
    s_waitcnt vmcnt(0)
    s_barrier
    s_branch R_loop
B_end:
    s_endpgm
.section .rodata,"a"
.p2align 6
.amdhsa_kernel sort_kernel
  .amdhsa_next_free_vgpr 64
  .amdhsa_next_free_sgpr 102
  .amdhsa_accum_offset 64
  .amdhsa_group_segment_fixed_size 0
  .amdhsa_kernarg_size 88
  .amdhsa_user_sgpr_count 2
  .amdhsa_user_sgpr_kernarg_segment_ptr 1
  .amdhsa_system_sgpr_workgroup_id_x 1
.end_amdhsa_kernel
.p2align 6
.amdhsa_kernel main_kernel
  .amdhsa_next_free_vgpr 256
  .amdhsa_next_free_sgpr 102
  .amdhsa_accum_offset 256
  .amdhsa_group_segment_fixed_size 0
  .amdhsa_kernarg_size 88
  .amdhsa_user_sgpr_count 2
  .amdhsa_user_sgpr_kernarg_segment_ptr 1
  .amdhsa_system_sgpr_workgroup_id_x 1
.end_amdhsa_kernel
```
